```python
import torch

def _softmax(x, axis=-1):
    return torch.softmax(x, dim=axis)
def _gelu(x):
    return torch.nn.functional.gelu(x, approximate="tanh")
def _silu(x):
    return torch.nn.functional.silu(x)
def _sigmoid(x):
    return torch.sigmoid(x)
def _layernorm(x, axis=-1, eps=1e-5):
    m = x.mean(dim=axis, keepdim=True)
    v = x.var(dim=axis, keepdim=True, unbiased=False)
    return (x - m) / torch.sqrt(v + eps)
def _scatter_add(tgt, idx, src, axis=0):
    return tgt.clone().index_add_(axis, idx, src)
def _segment_sum(src, seg, n):
    out = torch.zeros((n,) + src.shape[1:], dtype=src.dtype)
    return out.index_add_(0, seg, src)
def _pad(x, pw):
    flat = tuple(v for pair in reversed(pw) for v in pair)
    return torch.nn.functional.pad(x, flat)

kernel_name = 'concat_heads__gqa_block_cached__gqa_block_cached__decode'

def setup_inputs():

    _w = (lambda a: (lambda t: t.to(torch.bfloat16) if t.is_floating_point() else t)(torch.as_tensor(a)))
    def _A_setup():
        B, Sq, D = 2, 1, 512
        Hq, Hkv, Sk, Dh = 32, 32, 8192, 128
        assert Hq % Hkv == 0, (Hq, Hkv)
        return {
            "x": _w((lambda *s: torch.randn(*s, dtype=torch.bfloat16) * 0.8)(B, Sq, D)),
            "k_cache": _w((lambda *s: torch.randn(*s, dtype=torch.bfloat16) * 0.8)(B, Hkv, Sk, Dh)),
            "v_cache": _w((lambda *s: torch.randn(*s, dtype=torch.bfloat16) * 0.05)(B, Hkv, Sk, Dh)),
            "wq": _w((lambda *s: torch.randn(*s, dtype=torch.bfloat16) * 0.8)(D, Hq * Dh) * (D ** -0.5)),
            "wo": _w((lambda *s: torch.randn(*s, dtype=torch.bfloat16) * 0.05)(Hq * Dh, D) * ((Hq * Dh) ** -0.5)),
        }
    _A_in = _A_setup()

    def _B_setup():
        B, Sq, D = 2, 1, 512
        Hq, Hkv, Sk, Dh = 32, 32, 8192, 128
        assert Hq % Hkv == 0, (Hq, Hkv)
        return {
            "x": _w((lambda *s: torch.randn(*s, dtype=torch.bfloat16) * 0.8)(B, Sq, D)),
            "k_cache": _w((lambda *s: torch.randn(*s, dtype=torch.bfloat16) * 0.8)(B, Hkv, Sk, Dh)),
            "v_cache": _w((lambda *s: torch.randn(*s, dtype=torch.bfloat16) * 0.05)(B, Hkv, Sk, Dh)),
            "wq": _w((lambda *s: torch.randn(*s, dtype=torch.bfloat16) * 0.8)(D, Hq * Dh) * (D ** -0.5)),
            "wo": _w((lambda *s: torch.randn(*s, dtype=torch.bfloat16) * 0.05)(Hq * Dh, D) * ((Hq * Dh) ** -0.5)),
        }
    _B_in = _B_setup()

    return {
        "A_x": _A_in["x"],
        "A_k_cache": _A_in["k_cache"],
        "A_v_cache": _A_in["v_cache"],
        "A_wq": _A_in["wq"],
        "A_wo": _A_in["wo"],
        "B_x": _B_in["x"],
        "B_k_cache": _B_in["k_cache"],
        "B_v_cache": _B_in["v_cache"],
        "B_wq": _B_in["wq"],
        "B_wo": _B_in["wo"],
    }

def reference(A_x, A_k_cache, A_v_cache, A_wq, A_wo, B_x, B_k_cache, B_v_cache, B_wq, B_wo):
    def _A_ref(x, k_cache, v_cache, wq, wo):
        B, Sq, D = x.shape
        Hq, Dh = 32, 128
        Hkv = k_cache.shape[1]
        rep = Hq // Hkv
        q = (lambda x, *d: x.permute(*d))((x @ wq).reshape(B, Sq, Hq, Dh), 0, 2, 1, 3)
        k = (lambda x, n, axis: torch.repeat_interleave(x, n, dim=axis))(k_cache, rep, axis=1)
        v = (lambda x, n, axis: torch.repeat_interleave(x, n, dim=axis))(v_cache, rep, axis=1)
        scores = torch.einsum("bhqd,bhkd->bhqk", q, k) * (Dh ** -0.5)
        p = _softmax(scores, axis=-1)
        o = torch.einsum("bhqk,bhkd->bhqd", p, v)
        return (lambda x, *d: x.permute(*d))(o, 0, 2, 1, 3).reshape(B, Sq, Hq * Dh) @ wo

    def _B_ref(x, k_cache, v_cache, wq, wo):
        B, Sq, D = x.shape
        Hq, Dh = 32, 128
        Hkv = k_cache.shape[1]
        rep = Hq // Hkv
        q = (lambda x, *d: x.permute(*d))((x @ wq).reshape(B, Sq, Hq, Dh), 0, 2, 1, 3)
        k = (lambda x, n, axis: torch.repeat_interleave(x, n, dim=axis))(k_cache, rep, axis=1)
        v = (lambda x, n, axis: torch.repeat_interleave(x, n, dim=axis))(v_cache, rep, axis=1)
        scores = torch.einsum("bhqd,bhkd->bhqk", q, k) * (Dh ** -0.5)
        p = _softmax(scores, axis=-1)
        o = torch.einsum("bhqk,bhkd->bhqd", p, v)
        return (lambda x, *d: x.permute(*d))(o, 0, 2, 1, 3).reshape(B, Sq, Hq * Dh) @ wo

    a = _A_ref(A_x, A_k_cache, A_v_cache, A_wq, A_wo)
    b = _B_ref(B_x, B_k_cache, B_v_cache, B_wq, B_wo)
    return torch.concatenate([a, b], axis=-1)
```

```asm
; @launch kernel=attn_main_kernel grid=(256,1,1) block=(512,1,1) lds=158976
; @launch kernel=fin2_kernel grid=(32,1,1) block=(256,1,1) lds=0
.amdgcn_target "amdgcn-amd-amdhsa--gfx950"
.text
.globl attn_main_kernel
.p2align 8
.type attn_main_kernel,@function
attn_main_kernel:

  s_load_dwordx2 s[16:17], s[0:1], 96
  s_cmp_ge_u32 s2, 256
  s_cbranch_scc1 attn_main_kernel_end
  s_lshr_b32 s46, s2, 3
  s_lshr_b32 s42, s46, 4
  s_mul_i32 s3, s42, 40
  s_add_u32 s14, s0, s3
  s_addc_u32 s15, s1, 0
  s_load_dwordx8 s[4:11], s[14:15], 0
  s_load_dwordx2 s[12:13], s[14:15], 32
  s_and_b32 s40, s2, 7
  s_and_b32 s41, s46, 3
  s_lshr_b32 s43, s46, 2
  s_and_b32 s43, s43, 3
  s_lshl_b32 s43, s43, 3
  s_add_u32 s43, s43, s40
  s_lshr_b32 s44, s41, 1
  s_and_b32 s45, s41, 1
  v_lshrrev_b32 v2, 6, v0
  v_and_b32 v3, 63, v0
  v_readfirstlane_b32 s47, v2
  v_lshlrev_b32 v1, 4, v3
  v_lshrrev_b32 v32, 4, v3
  v_and_b32 v33, 15, v3
  v_lshlrev_b32 v30, 13, v32
  v_lshl_add_u32 v30, v33, 4, v30
  v_lshl_add_u32 v31, v33, 2, v32
  v_lshlrev_b32 v31, 1, v31
  v_lshlrev_b32 v36, 2, v0
  v_and_b32 v37, 12, v33
  v_add_u32 v37, v37, v32
  v_lshlrev_b32 v37, 2, v37
  v_add_u32 v37, 135168, v37
  s_mov_b32 s49, 0x3e0293ee
  s_lshl_b32 s52, s44, 5
  s_add_u32 s52, s52, s43
  s_lshl_b32 s52, s52, 1
  s_add_u32 s52, s52, s45
  s_lshl_b32 s58, s42, 7
  s_add_u32 s58, s58, s52
  s_lshl_b32 s53, s52, 20
  s_lshl_b32 s55, s43, 17
  s_lshl_b32 s46, s41, 1
  s_add_u32 s50, s47, s46
  s_and_b32 s50, s50, 7
  s_waitcnt lgkmcnt(0)
  s_mov_b32 s32, s4
  s_and_b32 s33, s5, 0xffff
  s_mov_b32 s34, 2048
  s_mov_b32 s35, 0x20000
  s_mov_b32 s28, s10
  s_and_b32 s29, s11, 0xffff
  s_mov_b32 s30, 4194304
  s_mov_b32 s31, 0x20000
  s_lshl_b32 s51, s44, 10
  s_lshl_b32 s46, s50, 7
  s_add_u32 s51, s51, s46
  buffer_load_ushort v28, v31, s[32:35], s51 offen
  s_lshl_b32 s51, s50, 19
  s_lshl_b32 s46, s43, 8
  s_add_u32 s51, s51, s46
  buffer_load_dwordx4 v[72:75], v30, s[28:31], s51 offen nt
  s_add_u32 s51, s51, 32768
  buffer_load_dwordx4 v[76:79], v30, s[28:31], s51 offen nt
  s_add_u32 s51, s51, 32768
  buffer_load_dwordx4 v[80:83], v30, s[28:31], s51 offen nt
  s_add_u32 s51, s51, 32768
  buffer_load_dwordx4 v[84:87], v30, s[28:31], s51 offen nt
  s_add_u32 s51, s51, 32768
  buffer_load_dwordx4 v[88:91], v30, s[28:31], s51 offen nt
  s_add_u32 s51, s51, 32768
  buffer_load_dwordx4 v[92:95], v30, s[28:31], s51 offen nt
  s_add_u32 s51, s51, 32768
  buffer_load_dwordx4 v[96:99], v30, s[28:31], s51 offen nt
  s_add_u32 s51, s51, 32768
  buffer_load_dwordx4 v[100:103], v30, s[28:31], s51 offen nt
  s_add_u32 s51, s51, 32768
  buffer_load_dwordx4 v[104:107], v30, s[28:31], s51 offen nt
  s_add_u32 s51, s51, 32768
  buffer_load_dwordx4 v[108:111], v30, s[28:31], s51 offen nt
  s_add_u32 s51, s51, 32768
  buffer_load_dwordx4 v[112:115], v30, s[28:31], s51 offen nt
  s_add_u32 s51, s51, 32768
  buffer_load_dwordx4 v[116:119], v30, s[28:31], s51 offen nt
  s_add_u32 s51, s51, 32768
  buffer_load_dwordx4 v[120:123], v30, s[28:31], s51 offen nt
  s_add_u32 s51, s51, 32768
  buffer_load_dwordx4 v[124:127], v30, s[28:31], s51 offen nt
  s_add_u32 s51, s51, 32768
  buffer_load_dwordx4 v[128:131], v30, s[28:31], s51 offen nt
  s_add_u32 s51, s51, 32768
  buffer_load_dwordx4 v[132:135], v30, s[28:31], s51 offen nt
  s_mov_b32 s20, s6
  s_and_b32 s21, s7, 0xffff
  s_mov_b32 s22, 134217728
  s_mov_b32 s23, 0x20000
  s_mov_b32 s24, s8
  s_and_b32 s25, s9, 0xffff
  s_mov_b32 s26, 134217728
  s_mov_b32 s27, 0x20000
  s_mov_b32 s60, s12
  s_and_b32 s61, s13, 0xffff
  s_mov_b32 s62, 4194304
  s_mov_b32 s63, 0x20000
  s_mov_b32 s36, s16
  s_and_b32 s37, s17, 0xffff
  s_mov_b32 s38, 526336
  s_mov_b32 s39, 0x20000
  s_mov_b32 s80, s6
  s_and_b32 s81, s7, 0xffff
  s_mov_b32 s82, 134217728
  s_mov_b32 s83, 0x20000
  s_cmp_ge_u32 s47, 5
  s_cselect_b32 s82, 0, s82
  s_mov_b32 s48, s47
  s_lshl_b32 s56, s47, 12
  s_add_u32 s56, s56, s53
  v_mov_b32 v34, 155776
  v_mov_b32 v35, 1
  v_mov_b32 v3, 10
  s_mov_b64 exec, 1
  ds_write_b32 v34, v3
  s_mov_b64 exec, -1
  v_mov_b32 v8, 0
  v_mov_b32 v9, 0
  v_mov_b32 v10, 0
  v_mov_b32 v11, 0
  v_mov_b32 v12, 0
  v_mov_b32 v13, 0
  v_mov_b32 v14, 0
  v_mov_b32 v15, 0
  s_lshl_b32 s54, s47, 14
  s_mul_i32 s19, s47, 16896
  s_barrier
  s_waitcnt vmcnt(16)
  v_lshlrev_b32 v29, 16, v28
  buffer_load_dwordx4 v[40:43], v1, s[80:83], s56 offen offset:0 nt
  buffer_load_dwordx4 v[44:47], v1, s[80:83], s56 offen offset:1024 nt
  buffer_load_dwordx4 v[48:51], v1, s[80:83], s56 offen offset:2048 nt
  buffer_load_dwordx4 v[52:55], v1, s[80:83], s56 offen offset:3072 nt
  s_waitcnt vmcnt(19)
  v_dot2c_f32_bf16_dpp v8, v28, v72 row_newbcast:0 row_mask:0xf bank_mask:0xf
  v_dot2c_f32_bf16_dpp v9, v29, v72 row_newbcast:0 row_mask:0xf bank_mask:0xf
  v_dot2c_f32_bf16_dpp v10, v28, v73 row_newbcast:0 row_mask:0xf bank_mask:0xf
  v_dot2c_f32_bf16_dpp v11, v29, v73 row_newbcast:0 row_mask:0xf bank_mask:0xf
  v_dot2c_f32_bf16_dpp v12, v28, v74 row_newbcast:0 row_mask:0xf bank_mask:0xf
  v_dot2c_f32_bf16_dpp v13, v29, v74 row_newbcast:0 row_mask:0xf bank_mask:0xf
  v_dot2c_f32_bf16_dpp v14, v28, v75 row_newbcast:0 row_mask:0xf bank_mask:0xf
  v_dot2c_f32_bf16_dpp v15, v29, v75 row_newbcast:0 row_mask:0xf bank_mask:0xf
  s_waitcnt vmcnt(18)
  v_dot2c_f32_bf16_dpp v8, v28, v76 row_newbcast:1 row_mask:0xf bank_mask:0xf
  v_dot2c_f32_bf16_dpp v9, v29, v76 row_newbcast:1 row_mask:0xf bank_mask:0xf
  v_dot2c_f32_bf16_dpp v10, v28, v77 row_newbcast:1 row_mask:0xf bank_mask:0xf
  v_dot2c_f32_bf16_dpp v11, v29, v77 row_newbcast:1 row_mask:0xf bank_mask:0xf
  v_dot2c_f32_bf16_dpp v12, v28, v78 row_newbcast:1 row_mask:0xf bank_mask:0xf
  v_dot2c_f32_bf16_dpp v13, v29, v78 row_newbcast:1 row_mask:0xf bank_mask:0xf
  v_dot2c_f32_bf16_dpp v14, v28, v79 row_newbcast:1 row_mask:0xf bank_mask:0xf
  v_dot2c_f32_bf16_dpp v15, v29, v79 row_newbcast:1 row_mask:0xf bank_mask:0xf
  s_waitcnt vmcnt(17)
  v_dot2c_f32_bf16_dpp v8, v28, v80 row_newbcast:2 row_mask:0xf bank_mask:0xf
  v_dot2c_f32_bf16_dpp v9, v29, v80 row_newbcast:2 row_mask:0xf bank_mask:0xf
  v_dot2c_f32_bf16_dpp v10, v28, v81 row_newbcast:2 row_mask:0xf bank_mask:0xf
  v_dot2c_f32_bf16_dpp v11, v29, v81 row_newbcast:2 row_mask:0xf bank_mask:0xf
  v_dot2c_f32_bf16_dpp v12, v28, v82 row_newbcast:2 row_mask:0xf bank_mask:0xf
  v_dot2c_f32_bf16_dpp v13, v29, v82 row_newbcast:2 row_mask:0xf bank_mask:0xf
  v_dot2c_f32_bf16_dpp v14, v28, v83 row_newbcast:2 row_mask:0xf bank_mask:0xf
  v_dot2c_f32_bf16_dpp v15, v29, v83 row_newbcast:2 row_mask:0xf bank_mask:0xf
  s_waitcnt vmcnt(16)
  v_dot2c_f32_bf16_dpp v8, v28, v84 row_newbcast:3 row_mask:0xf bank_mask:0xf
  v_dot2c_f32_bf16_dpp v9, v29, v84 row_newbcast:3 row_mask:0xf bank_mask:0xf
  v_dot2c_f32_bf16_dpp v10, v28, v85 row_newbcast:3 row_mask:0xf bank_mask:0xf
  v_dot2c_f32_bf16_dpp v11, v29, v85 row_newbcast:3 row_mask:0xf bank_mask:0xf
  v_dot2c_f32_bf16_dpp v12, v28, v86 row_newbcast:3 row_mask:0xf bank_mask:0xf
  v_dot2c_f32_bf16_dpp v13, v29, v86 row_newbcast:3 row_mask:0xf bank_mask:0xf
  v_dot2c_f32_bf16_dpp v14, v28, v87 row_newbcast:3 row_mask:0xf bank_mask:0xf
  v_dot2c_f32_bf16_dpp v15, v29, v87 row_newbcast:3 row_mask:0xf bank_mask:0xf
  s_waitcnt vmcnt(15)
  v_dot2c_f32_bf16_dpp v8, v28, v88 row_newbcast:4 row_mask:0xf bank_mask:0xf
  v_dot2c_f32_bf16_dpp v9, v29, v88 row_newbcast:4 row_mask:0xf bank_mask:0xf
  v_dot2c_f32_bf16_dpp v10, v28, v89 row_newbcast:4 row_mask:0xf bank_mask:0xf
  v_dot2c_f32_bf16_dpp v11, v29, v89 row_newbcast:4 row_mask:0xf bank_mask:0xf
  v_dot2c_f32_bf16_dpp v12, v28, v90 row_newbcast:4 row_mask:0xf bank_mask:0xf
  v_dot2c_f32_bf16_dpp v13, v29, v90 row_newbcast:4 row_mask:0xf bank_mask:0xf
  v_dot2c_f32_bf16_dpp v14, v28, v91 row_newbcast:4 row_mask:0xf bank_mask:0xf
  v_dot2c_f32_bf16_dpp v15, v29, v91 row_newbcast:4 row_mask:0xf bank_mask:0xf
  s_waitcnt vmcnt(14)
  v_dot2c_f32_bf16_dpp v8, v28, v92 row_newbcast:5 row_mask:0xf bank_mask:0xf
  v_dot2c_f32_bf16_dpp v9, v29, v92 row_newbcast:5 row_mask:0xf bank_mask:0xf
  v_dot2c_f32_bf16_dpp v10, v28, v93 row_newbcast:5 row_mask:0xf bank_mask:0xf
  v_dot2c_f32_bf16_dpp v11, v29, v93 row_newbcast:5 row_mask:0xf bank_mask:0xf
  v_dot2c_f32_bf16_dpp v12, v28, v94 row_newbcast:5 row_mask:0xf bank_mask:0xf
  v_dot2c_f32_bf16_dpp v13, v29, v94 row_newbcast:5 row_mask:0xf bank_mask:0xf
  v_dot2c_f32_bf16_dpp v14, v28, v95 row_newbcast:5 row_mask:0xf bank_mask:0xf
  v_dot2c_f32_bf16_dpp v15, v29, v95 row_newbcast:5 row_mask:0xf bank_mask:0xf
  s_waitcnt vmcnt(13)
  v_dot2c_f32_bf16_dpp v8, v28, v96 row_newbcast:6 row_mask:0xf bank_mask:0xf
  v_dot2c_f32_bf16_dpp v9, v29, v96 row_newbcast:6 row_mask:0xf bank_mask:0xf
  v_dot2c_f32_bf16_dpp v10, v28, v97 row_newbcast:6 row_mask:0xf bank_mask:0xf
  v_dot2c_f32_bf16_dpp v11, v29, v97 row_newbcast:6 row_mask:0xf bank_mask:0xf
  v_dot2c_f32_bf16_dpp v12, v28, v98 row_newbcast:6 row_mask:0xf bank_mask:0xf
  v_dot2c_f32_bf16_dpp v13, v29, v98 row_newbcast:6 row_mask:0xf bank_mask:0xf
  v_dot2c_f32_bf16_dpp v14, v28, v99 row_newbcast:6 row_mask:0xf bank_mask:0xf
  v_dot2c_f32_bf16_dpp v15, v29, v99 row_newbcast:6 row_mask:0xf bank_mask:0xf
  s_waitcnt vmcnt(12)
  v_dot2c_f32_bf16_dpp v8, v28, v100 row_newbcast:7 row_mask:0xf bank_mask:0xf
  v_dot2c_f32_bf16_dpp v9, v29, v100 row_newbcast:7 row_mask:0xf bank_mask:0xf
  v_dot2c_f32_bf16_dpp v10, v28, v101 row_newbcast:7 row_mask:0xf bank_mask:0xf
  v_dot2c_f32_bf16_dpp v11, v29, v101 row_newbcast:7 row_mask:0xf bank_mask:0xf
  v_dot2c_f32_bf16_dpp v12, v28, v102 row_newbcast:7 row_mask:0xf bank_mask:0xf
  v_dot2c_f32_bf16_dpp v13, v29, v102 row_newbcast:7 row_mask:0xf bank_mask:0xf
  v_dot2c_f32_bf16_dpp v14, v28, v103 row_newbcast:7 row_mask:0xf bank_mask:0xf
  v_dot2c_f32_bf16_dpp v15, v29, v103 row_newbcast:7 row_mask:0xf bank_mask:0xf
  s_waitcnt vmcnt(11)
  v_dot2c_f32_bf16_dpp v8, v28, v104 row_newbcast:8 row_mask:0xf bank_mask:0xf
  v_dot2c_f32_bf16_dpp v9, v29, v104 row_newbcast:8 row_mask:0xf bank_mask:0xf
  v_dot2c_f32_bf16_dpp v10, v28, v105 row_newbcast:8 row_mask:0xf bank_mask:0xf
  v_dot2c_f32_bf16_dpp v11, v29, v105 row_newbcast:8 row_mask:0xf bank_mask:0xf
  v_dot2c_f32_bf16_dpp v12, v28, v106 row_newbcast:8 row_mask:0xf bank_mask:0xf
  v_dot2c_f32_bf16_dpp v13, v29, v106 row_newbcast:8 row_mask:0xf bank_mask:0xf
  v_dot2c_f32_bf16_dpp v14, v28, v107 row_newbcast:8 row_mask:0xf bank_mask:0xf
  v_dot2c_f32_bf16_dpp v15, v29, v107 row_newbcast:8 row_mask:0xf bank_mask:0xf
  s_waitcnt vmcnt(10)
  v_dot2c_f32_bf16_dpp v8, v28, v108 row_newbcast:9 row_mask:0xf bank_mask:0xf
  v_dot2c_f32_bf16_dpp v9, v29, v108 row_newbcast:9 row_mask:0xf bank_mask:0xf
  v_dot2c_f32_bf16_dpp v10, v28, v109 row_newbcast:9 row_mask:0xf bank_mask:0xf
  v_dot2c_f32_bf16_dpp v11, v29, v109 row_newbcast:9 row_mask:0xf bank_mask:0xf
  v_dot2c_f32_bf16_dpp v12, v28, v110 row_newbcast:9 row_mask:0xf bank_mask:0xf
  v_dot2c_f32_bf16_dpp v13, v29, v110 row_newbcast:9 row_mask:0xf bank_mask:0xf
  v_dot2c_f32_bf16_dpp v14, v28, v111 row_newbcast:9 row_mask:0xf bank_mask:0xf
  v_dot2c_f32_bf16_dpp v15, v29, v111 row_newbcast:9 row_mask:0xf bank_mask:0xf
  s_waitcnt vmcnt(9)
  v_dot2c_f32_bf16_dpp v8, v28, v112 row_newbcast:10 row_mask:0xf bank_mask:0xf
  v_dot2c_f32_bf16_dpp v9, v29, v112 row_newbcast:10 row_mask:0xf bank_mask:0xf
  v_dot2c_f32_bf16_dpp v10, v28, v113 row_newbcast:10 row_mask:0xf bank_mask:0xf
  v_dot2c_f32_bf16_dpp v11, v29, v113 row_newbcast:10 row_mask:0xf bank_mask:0xf
  v_dot2c_f32_bf16_dpp v12, v28, v114 row_newbcast:10 row_mask:0xf bank_mask:0xf
  v_dot2c_f32_bf16_dpp v13, v29, v114 row_newbcast:10 row_mask:0xf bank_mask:0xf
  v_dot2c_f32_bf16_dpp v14, v28, v115 row_newbcast:10 row_mask:0xf bank_mask:0xf
  v_dot2c_f32_bf16_dpp v15, v29, v115 row_newbcast:10 row_mask:0xf bank_mask:0xf
  s_waitcnt vmcnt(8)
  v_dot2c_f32_bf16_dpp v8, v28, v116 row_newbcast:11 row_mask:0xf bank_mask:0xf
  v_dot2c_f32_bf16_dpp v9, v29, v116 row_newbcast:11 row_mask:0xf bank_mask:0xf
  v_dot2c_f32_bf16_dpp v10, v28, v117 row_newbcast:11 row_mask:0xf bank_mask:0xf
  v_dot2c_f32_bf16_dpp v11, v29, v117 row_newbcast:11 row_mask:0xf bank_mask:0xf
  v_dot2c_f32_bf16_dpp v12, v28, v118 row_newbcast:11 row_mask:0xf bank_mask:0xf
  v_dot2c_f32_bf16_dpp v13, v29, v118 row_newbcast:11 row_mask:0xf bank_mask:0xf
  v_dot2c_f32_bf16_dpp v14, v28, v119 row_newbcast:11 row_mask:0xf bank_mask:0xf
  v_dot2c_f32_bf16_dpp v15, v29, v119 row_newbcast:11 row_mask:0xf bank_mask:0xf
  s_waitcnt vmcnt(7)
  v_dot2c_f32_bf16_dpp v8, v28, v120 row_newbcast:12 row_mask:0xf bank_mask:0xf
  v_dot2c_f32_bf16_dpp v9, v29, v120 row_newbcast:12 row_mask:0xf bank_mask:0xf
  v_dot2c_f32_bf16_dpp v10, v28, v121 row_newbcast:12 row_mask:0xf bank_mask:0xf
  v_dot2c_f32_bf16_dpp v11, v29, v121 row_newbcast:12 row_mask:0xf bank_mask:0xf
  v_dot2c_f32_bf16_dpp v12, v28, v122 row_newbcast:12 row_mask:0xf bank_mask:0xf
  v_dot2c_f32_bf16_dpp v13, v29, v122 row_newbcast:12 row_mask:0xf bank_mask:0xf
  v_dot2c_f32_bf16_dpp v14, v28, v123 row_newbcast:12 row_mask:0xf bank_mask:0xf
  v_dot2c_f32_bf16_dpp v15, v29, v123 row_newbcast:12 row_mask:0xf bank_mask:0xf
  s_waitcnt vmcnt(6)
  v_dot2c_f32_bf16_dpp v8, v28, v124 row_newbcast:13 row_mask:0xf bank_mask:0xf
  v_dot2c_f32_bf16_dpp v9, v29, v124 row_newbcast:13 row_mask:0xf bank_mask:0xf
  v_dot2c_f32_bf16_dpp v10, v28, v125 row_newbcast:13 row_mask:0xf bank_mask:0xf
  v_dot2c_f32_bf16_dpp v11, v29, v125 row_newbcast:13 row_mask:0xf bank_mask:0xf
  v_dot2c_f32_bf16_dpp v12, v28, v126 row_newbcast:13 row_mask:0xf bank_mask:0xf
  v_dot2c_f32_bf16_dpp v13, v29, v126 row_newbcast:13 row_mask:0xf bank_mask:0xf
  v_dot2c_f32_bf16_dpp v14, v28, v127 row_newbcast:13 row_mask:0xf bank_mask:0xf
  v_dot2c_f32_bf16_dpp v15, v29, v127 row_newbcast:13 row_mask:0xf bank_mask:0xf
  s_waitcnt vmcnt(5)
  v_dot2c_f32_bf16_dpp v8, v28, v128 row_newbcast:14 row_mask:0xf bank_mask:0xf
  v_dot2c_f32_bf16_dpp v9, v29, v128 row_newbcast:14 row_mask:0xf bank_mask:0xf
  v_dot2c_f32_bf16_dpp v10, v28, v129 row_newbcast:14 row_mask:0xf bank_mask:0xf
  v_dot2c_f32_bf16_dpp v11, v29, v129 row_newbcast:14 row_mask:0xf bank_mask:0xf
  v_dot2c_f32_bf16_dpp v12, v28, v130 row_newbcast:14 row_mask:0xf bank_mask:0xf
  v_dot2c_f32_bf16_dpp v13, v29, v130 row_newbcast:14 row_mask:0xf bank_mask:0xf
  v_dot2c_f32_bf16_dpp v14, v28, v131 row_newbcast:14 row_mask:0xf bank_mask:0xf
  v_dot2c_f32_bf16_dpp v15, v29, v131 row_newbcast:14 row_mask:0xf bank_mask:0xf
  s_waitcnt vmcnt(4)
  v_dot2c_f32_bf16_dpp v8, v28, v132 row_newbcast:15 row_mask:0xf bank_mask:0xf
  v_dot2c_f32_bf16_dpp v9, v29, v132 row_newbcast:15 row_mask:0xf bank_mask:0xf
  v_dot2c_f32_bf16_dpp v10, v28, v133 row_newbcast:15 row_mask:0xf bank_mask:0xf
  v_dot2c_f32_bf16_dpp v11, v29, v133 row_newbcast:15 row_mask:0xf bank_mask:0xf
  v_dot2c_f32_bf16_dpp v12, v28, v134 row_newbcast:15 row_mask:0xf bank_mask:0xf
  v_dot2c_f32_bf16_dpp v13, v29, v134 row_newbcast:15 row_mask:0xf bank_mask:0xf
  v_dot2c_f32_bf16_dpp v14, v28, v135 row_newbcast:15 row_mask:0xf bank_mask:0xf
  v_dot2c_f32_bf16_dpp v15, v29, v135 row_newbcast:15 row_mask:0xf bank_mask:0xf
  v_permlane32_swap_b32 v8, v12
  v_permlane32_swap_b32 v9, v13
  v_permlane32_swap_b32 v10, v14
  v_permlane32_swap_b32 v11, v15
  v_add_f32 v8, v8, v12
  v_add_f32 v9, v9, v13
  v_add_f32 v10, v10, v14
  v_add_f32 v11, v11, v15
  s_nop 0
  v_permlane16_swap_b32 v8, v10
  v_permlane16_swap_b32 v9, v11
  v_add_f32 v8, v8, v10
  v_add_f32 v9, v9, v11
  v_lshlrev_b32 v2, 5, v33
  v_lshl_add_u32 v2, v32, 3, v2
  s_lshl_b32 s51, s47, 9
  s_add_u32 s51, s51, 151552
  v_add_u32 v27, s51, v2
  ds_write_b64 v27, v[8:9]
  s_add_u32 s46, s56, 20480
  buffer_load_dwordx4 v[56:59], v1, s[80:83], s46 offen offset:0 nt
  buffer_load_dwordx4 v[60:63], v1, s[80:83], s46 offen offset:1024 nt
  buffer_load_dwordx4 v[64:67], v1, s[80:83], s46 offen offset:2048 nt
  buffer_load_dwordx4 v[68:71], v1, s[80:83], s46 offen offset:3072 nt
  s_waitcnt lgkmcnt(0)
  s_barrier
  v_lshrrev_b32 v2, 1, v1
  v_add_u32 v2, 151552, v2
  ds_read_b64 v[72:73], v2 offset:0
  ds_read_b64 v[74:75], v2 offset:512
  ds_read_b64 v[76:77], v2 offset:1024
  ds_read_b64 v[78:79], v2 offset:1536
  ds_read_b64 v[80:81], v2 offset:2048
  ds_read_b64 v[82:83], v2 offset:2560
  ds_read_b64 v[84:85], v2 offset:3072
  ds_read_b64 v[86:87], v2 offset:3584
  s_waitcnt lgkmcnt(0)
  v_add_f32 v72, v72, v74
  v_add_f32 v73, v73, v75
  v_add_f32 v76, v76, v78
  v_add_f32 v77, v77, v79
  v_add_f32 v80, v80, v82
  v_add_f32 v81, v81, v83
  v_add_f32 v84, v84, v86
  v_add_f32 v85, v85, v87
  v_add_f32 v72, v72, v76
  v_add_f32 v73, v73, v77
  v_add_f32 v80, v80, v84
  v_add_f32 v81, v81, v85
  v_add_f32 v72, v72, v80
  v_add_f32 v73, v73, v81
  v_cvt_pk_bf16_f32 v3, v72, v73
  v_lshlrev_b32 v2, 4, v33
  v_add_u32 v26, 0, v2
  ds_bpermute_b32 v4, v26, v3
  v_add_u32 v26, 4, v2
  ds_bpermute_b32 v5, v26, v3
  v_add_u32 v26, 8, v2
  ds_bpermute_b32 v6, v26, v3
  v_add_u32 v26, 12, v2
  ds_bpermute_b32 v7, v26, v3
  v_mov_b32 v8, 0
  v_mov_b32 v9, 0
  v_mov_b32 v10, 0
  v_mov_b32 v11, 0
  v_mov_b32 v12, 0
  v_mov_b32 v13, 0
  v_mov_b32 v14, 0
  v_mov_b32 v15, 0
  v_mov_b32 v16, 0xff61b1e6
  s_mov_b32 s50, 0
  s_waitcnt lgkmcnt(0)
  s_cmp_lt_u32 s47, 5
  s_cbranch_scc1 attn_main_kernel_active
  s_waitcnt vmcnt(0)
  s_branch attn_main_kernel_wofin
attn_main_kernel_active:
  s_mov_b32 s57, s48
  s_mov_b64 exec, 1
  ds_add_rtn_u32 v2, v34, v35
  s_mov_b64 exec, -1
  s_waitcnt lgkmcnt(0)
  v_readfirstlane_b32 s48, v2
  s_nop 3
  s_and_b32 s46, s48, 255
  s_lshl_b32 s56, s46, 12
  s_add_u32 s56, s56, s53
  s_cmp_lt_u32 s48, 256
  s_cselect_b32 s80, s20, s24
  s_cselect_b32 s81, s21, s25
  s_cmp_lt_u32 s48, 512
  s_cselect_b32 s82, s22, 0
  s_waitcnt vmcnt(7)
  v_dot2_f32_bf16 v20, v40, v4, 0
  v_dot2c_f32_bf16 v20, v41, v5
  v_dot2c_f32_bf16 v20, v42, v6
  v_dot2c_f32_bf16 v20, v43, v7
  buffer_load_dwordx4 v[40:43], v1, s[80:83], s56 offen offset:0 nt
  s_waitcnt vmcnt(7)
  v_dot2_f32_bf16 v21, v44, v4, 0
  v_dot2c_f32_bf16 v21, v45, v5
  v_dot2c_f32_bf16 v21, v46, v6
  v_dot2c_f32_bf16 v21, v47, v7
  buffer_load_dwordx4 v[44:47], v1, s[80:83], s56 offen offset:1024 nt
  s_waitcnt vmcnt(7)
  v_dot2_f32_bf16 v22, v48, v4, 0
  v_dot2c_f32_bf16 v22, v49, v5
  v_dot2c_f32_bf16 v22, v50, v6
  v_dot2c_f32_bf16 v22, v51, v7
  buffer_load_dwordx4 v[48:51], v1, s[80:83], s56 offen offset:2048 nt
  s_waitcnt vmcnt(7)
  v_dot2_f32_bf16 v23, v52, v4, 0
  v_dot2c_f32_bf16 v23, v53, v5
  v_dot2c_f32_bf16 v23, v54, v6
  v_dot2c_f32_bf16 v23, v55, v7
  buffer_load_dwordx4 v[52:55], v1, s[80:83], s56 offen offset:3072 nt
  v_add_f32_dpp v20, v20, v20 row_ror:8 row_mask:0xf bank_mask:0x3
  v_add_f32_dpp v21, v21, v21 row_ror:8 row_mask:0xf bank_mask:0x3
  v_add_f32_dpp v20, v22, v22 row_ror:8 row_mask:0xf bank_mask:0xc
  v_add_f32_dpp v21, v23, v23 row_ror:8 row_mask:0xf bank_mask:0xc
  s_nop 0
  v_add_f32_dpp v20, v20, v20 row_half_mirror row_mask:0xf bank_mask:0x5
  v_add_f32_dpp v20, v21, v21 row_half_mirror row_mask:0xf bank_mask:0xa
  s_lshl_b32 s46, s57, 6
  v_add_u32 v3, s46, v37
  v_add_f32_dpp v20, v20, v20 quad_perm:[1,0,3,2] row_mask:0xf bank_mask:0xf
  s_nop 1
  v_add_f32_dpp v20, v20, v20 quad_perm:[2,3,0,1] row_mask:0xf bank_mask:0xf
  v_mul_f32 v20, s49, v20
  v_max_f32 v16, v16, v20
  s_mov_b32 exec_lo, 0x11111111
  s_mov_b32 exec_hi, 0x11111111
  ds_write_b32 v3, v20
  s_mov_b64 exec, -1
  s_add_u32 s57, s57, 5
  s_waitcnt lgkmcnt(0)
  s_waitcnt vmcnt(7)
  v_dot2_f32_bf16 v20, v56, v4, 0
  v_dot2c_f32_bf16 v20, v57, v5
  v_dot2c_f32_bf16 v20, v58, v6
  v_dot2c_f32_bf16 v20, v59, v7
  s_waitcnt vmcnt(6)
  v_dot2_f32_bf16 v21, v60, v4, 0
  v_dot2c_f32_bf16 v21, v61, v5
  v_dot2c_f32_bf16 v21, v62, v6
  v_dot2c_f32_bf16 v21, v63, v7
  s_waitcnt vmcnt(5)
  v_dot2_f32_bf16 v22, v64, v4, 0
  v_dot2c_f32_bf16 v22, v65, v5
  v_dot2c_f32_bf16 v22, v66, v6
  v_dot2c_f32_bf16 v22, v67, v7
  s_waitcnt vmcnt(4)
  v_dot2_f32_bf16 v23, v68, v4, 0
  v_dot2c_f32_bf16 v23, v69, v5
  v_dot2c_f32_bf16 v23, v70, v6
  v_dot2c_f32_bf16 v23, v71, v7
  v_add_f32_dpp v20, v20, v20 row_ror:8 row_mask:0xf bank_mask:0x3
  v_add_f32_dpp v21, v21, v21 row_ror:8 row_mask:0xf bank_mask:0x3
  v_add_f32_dpp v20, v22, v22 row_ror:8 row_mask:0xf bank_mask:0xc
  v_add_f32_dpp v21, v23, v23 row_ror:8 row_mask:0xf bank_mask:0xc
  s_nop 0
  v_add_f32_dpp v20, v20, v20 row_half_mirror row_mask:0xf bank_mask:0x5
  v_add_f32_dpp v20, v21, v21 row_half_mirror row_mask:0xf bank_mask:0xa
  s_lshl_b32 s46, s57, 6
  v_add_u32 v3, s46, v37
  v_add_f32_dpp v20, v20, v20 quad_perm:[1,0,3,2] row_mask:0xf bank_mask:0xf
  s_nop 1
  v_add_f32_dpp v20, v20, v20 quad_perm:[2,3,0,1] row_mask:0xf bank_mask:0xf
  v_mul_f32 v20, s49, v20
  v_max_f32 v16, v16, v20
  s_mov_b32 exec_lo, 0x11111111
  s_mov_b32 exec_hi, 0x11111111
  ds_write_b32 v3, v20
  s_mov_b64 exec, -1
attn_main_kernel_kloopa:
  s_mov_b32 s57, s48
  s_mov_b64 exec, 1
  ds_add_rtn_u32 v2, v34, v35
  s_mov_b64 exec, -1
  s_mov_b32 m0, s19
  s_add_u32 s51, s54, s55
  buffer_load_dwordx4 v1, s[60:63], s51 offen nt lds
  s_add_u32 s54, s54, 1024
  s_add_u32 s19, s19, 1056
  s_add_u32 s50, s50, 1
  s_waitcnt lgkmcnt(0)
  v_readfirstlane_b32 s48, v2
  s_nop 3
  s_and_b32 s46, s48, 255
  s_lshl_b32 s56, s46, 12
  s_add_u32 s56, s56, s53
  s_cmp_lt_u32 s48, 256
  s_cselect_b32 s80, s20, s24
  s_cselect_b32 s81, s21, s25
  s_cmp_lt_u32 s48, 512
  s_cselect_b32 s82, s22, 0
  s_waitcnt vmcnt(4)
  v_dot2_f32_bf16 v20, v40, v4, 0
  v_dot2c_f32_bf16 v20, v41, v5
  v_dot2c_f32_bf16 v20, v42, v6
  v_dot2c_f32_bf16 v20, v43, v7
  buffer_load_dwordx4 v[40:43], v1, s[80:83], s56 offen offset:0 nt
  s_waitcnt vmcnt(4)
  v_dot2_f32_bf16 v21, v44, v4, 0
  v_dot2c_f32_bf16 v21, v45, v5
  v_dot2c_f32_bf16 v21, v46, v6
  v_dot2c_f32_bf16 v21, v47, v7
  buffer_load_dwordx4 v[44:47], v1, s[80:83], s56 offen offset:1024 nt
  s_waitcnt vmcnt(4)
  v_dot2_f32_bf16 v22, v48, v4, 0
  v_dot2c_f32_bf16 v22, v49, v5
  v_dot2c_f32_bf16 v22, v50, v6
  v_dot2c_f32_bf16 v22, v51, v7
  buffer_load_dwordx4 v[48:51], v1, s[80:83], s56 offen offset:2048 nt
  s_waitcnt vmcnt(4)
  v_dot2_f32_bf16 v23, v52, v4, 0
  v_dot2c_f32_bf16 v23, v53, v5
  v_dot2c_f32_bf16 v23, v54, v6
  v_dot2c_f32_bf16 v23, v55, v7
  buffer_load_dwordx4 v[52:55], v1, s[80:83], s56 offen offset:3072 nt
  v_add_f32_dpp v20, v20, v20 row_ror:8 row_mask:0xf bank_mask:0x3
  v_add_f32_dpp v21, v21, v21 row_ror:8 row_mask:0xf bank_mask:0x3
  v_add_f32_dpp v20, v22, v22 row_ror:8 row_mask:0xf bank_mask:0xc
  v_add_f32_dpp v21, v23, v23 row_ror:8 row_mask:0xf bank_mask:0xc
  s_nop 0
  v_add_f32_dpp v20, v20, v20 row_half_mirror row_mask:0xf bank_mask:0x5
  v_add_f32_dpp v20, v21, v21 row_half_mirror row_mask:0xf bank_mask:0xa
  s_lshl_b32 s46, s57, 6
  v_add_u32 v3, s46, v37
  v_add_f32_dpp v20, v20, v20 quad_perm:[1,0,3,2] row_mask:0xf bank_mask:0xf
  s_nop 1
  v_add_f32_dpp v20, v20, v20 quad_perm:[2,3,0,1] row_mask:0xf bank_mask:0xf
  v_mul_f32 v20, s49, v20
  v_max_f32 v16, v16, v20
  s_mov_b32 exec_lo, 0x11111111
  s_mov_b32 exec_hi, 0x11111111
  ds_write_b32 v3, v20
  s_mov_b64 exec, -1
  s_cmp_ge_u32 s48, 256
  s_cbranch_scc1 attn_main_kernel_kdone
  s_cmp_lt_u32 s50, 16
  s_cbranch_scc1 attn_main_kernel_kloopa
attn_main_kernel_kloop:
  s_mov_b32 s57, s48
  s_mov_b64 exec, 1
  ds_add_rtn_u32 v2, v34, v35
  s_mov_b64 exec, -1
  s_waitcnt lgkmcnt(0)
  v_readfirstlane_b32 s48, v2
  s_nop 3
  s_and_b32 s46, s48, 255
  s_lshl_b32 s56, s46, 12
  s_add_u32 s56, s56, s53
  s_cmp_lt_u32 s48, 256
  s_cselect_b32 s80, s20, s24
  s_cselect_b32 s81, s21, s25
  s_cmp_lt_u32 s48, 512
  s_cselect_b32 s82, s22, 0
  s_waitcnt vmcnt(3)
  v_dot2_f32_bf16 v20, v40, v4, 0
  v_dot2c_f32_bf16 v20, v41, v5
  v_dot2c_f32_bf16 v20, v42, v6
  v_dot2c_f32_bf16 v20, v43, v7
  buffer_load_dwordx4 v[40:43], v1, s[80:83], s56 offen offset:0 nt
  s_waitcnt vmcnt(3)
  v_dot2_f32_bf16 v21, v44, v4, 0
  v_dot2c_f32_bf16 v21, v45, v5
  v_dot2c_f32_bf16 v21, v46, v6
  v_dot2c_f32_bf16 v21, v47, v7
  buffer_load_dwordx4 v[44:47], v1, s[80:83], s56 offen offset:1024 nt
  s_waitcnt vmcnt(3)
  v_dot2_f32_bf16 v22, v48, v4, 0
  v_dot2c_f32_bf16 v22, v49, v5
  v_dot2c_f32_bf16 v22, v50, v6
  v_dot2c_f32_bf16 v22, v51, v7
  buffer_load_dwordx4 v[48:51], v1, s[80:83], s56 offen offset:2048 nt
  s_waitcnt vmcnt(3)
  v_dot2_f32_bf16 v23, v52, v4, 0
  v_dot2c_f32_bf16 v23, v53, v5
  v_dot2c_f32_bf16 v23, v54, v6
  v_dot2c_f32_bf16 v23, v55, v7
  buffer_load_dwordx4 v[52:55], v1, s[80:83], s56 offen offset:3072 nt
  v_add_f32_dpp v20, v20, v20 row_ror:8 row_mask:0xf bank_mask:0x3
  v_add_f32_dpp v21, v21, v21 row_ror:8 row_mask:0xf bank_mask:0x3
  v_add_f32_dpp v20, v22, v22 row_ror:8 row_mask:0xf bank_mask:0xc
  v_add_f32_dpp v21, v23, v23 row_ror:8 row_mask:0xf bank_mask:0xc
  s_nop 0
  v_add_f32_dpp v20, v20, v20 row_half_mirror row_mask:0xf bank_mask:0x5
  v_add_f32_dpp v20, v21, v21 row_half_mirror row_mask:0xf bank_mask:0xa
  s_lshl_b32 s46, s57, 6
  v_add_u32 v3, s46, v37
  v_add_f32_dpp v20, v20, v20 quad_perm:[1,0,3,2] row_mask:0xf bank_mask:0xf
  s_nop 1
  v_add_f32_dpp v20, v20, v20 quad_perm:[2,3,0,1] row_mask:0xf bank_mask:0xf
  v_mul_f32 v20, s49, v20
  v_max_f32 v16, v16, v20
  s_mov_b32 exec_lo, 0x11111111
  s_mov_b32 exec_hi, 0x11111111
  ds_write_b32 v3, v20
  s_mov_b64 exec, -1
  s_cmp_lt_u32 s48, 256
  s_cbranch_scc1 attn_main_kernel_kloop
attn_main_kernel_kdone:
  s_mov_b32 s57, s48
  s_mov_b64 exec, 1
  ds_add_rtn_u32 v2, v34, v35
  s_mov_b64 exec, -1
  s_waitcnt lgkmcnt(0)
  v_readfirstlane_b32 s48, v2
  s_nop 3
  s_and_b32 s46, s48, 255
  s_lshl_b32 s56, s46, 12
  s_add_u32 s56, s56, s53
  s_cmp_lt_u32 s48, 256
  s_cselect_b32 s80, s20, s24
  s_cselect_b32 s81, s21, s25
  s_cmp_lt_u32 s48, 512
  s_cselect_b32 s82, s22, 0
  buffer_load_dwordx4 v[72:75], v1, s[80:83], s56 offen offset:0 nt
  buffer_load_dwordx4 v[76:79], v1, s[80:83], s56 offen offset:1024 nt
  buffer_load_dwordx4 v[80:83], v1, s[80:83], s56 offen offset:2048 nt
  buffer_load_dwordx4 v[84:87], v1, s[80:83], s56 offen offset:3072 nt
attn_main_kernel_wofin:
  s_cmp_ge_u32 s50, 16
  s_cbranch_scc1 attn_main_kernel_wodone
attn_main_kernel_woloop:
  s_mov_b32 m0, s19
  s_add_u32 s51, s54, s55
  buffer_load_dwordx4 v1, s[60:63], s51 offen nt lds
  s_add_u32 s54, s54, 1024
  s_add_u32 s19, s19, 1056
  s_add_u32 s50, s50, 1
  s_cmp_lt_u32 s50, 16
  s_cbranch_scc1 attn_main_kernel_woloop
  s_waitcnt vmcnt(0)
attn_main_kernel_wodone:
  v_max_f32_dpp v16, v16, v16 row_ror:4 row_mask:0xf bank_mask:0xf
  s_nop 1
  v_max_f32_dpp v16, v16, v16 row_ror:8 row_mask:0xf bank_mask:0xf
  v_mov_b32 v27, v16
  s_nop 1
  v_permlane32_swap_b32 v16, v27
  v_max_f32 v16, v16, v27
  v_mov_b32 v27, v16
  s_nop 1
  v_permlane16_swap_b32 v16, v27
  v_max_f32 v16, v16, v27
  s_lshl_b32 s51, s47, 2
  s_add_u32 s51, s51, 155648
  v_mov_b32 v2, s51
  s_mov_b64 exec, 1
  ds_write_b32 v2, v16
  s_mov_b64 exec, -1
  v_lshlrev_b32 v3, 5, v0
  v_add_u32 v3, 135168, v3
  v_mov_b32 v2, 155648
  s_waitcnt lgkmcnt(0)
  s_barrier
  ds_read_b128 v[56:59], v2
  ds_read_b128 v[60:63], v2 offset:16
  ds_read_b128 v[64:67], v3
  ds_read_b128 v[68:71], v3 offset:16
  s_waitcnt lgkmcnt(2)
  v_max3_f32 v16, v56, v57, v58
  v_max3_f32 v27, v59, v60, v61
  v_max3_f32 v16, v16, v62, v63
  v_max_f32 v16, v16, v27
  s_waitcnt lgkmcnt(0)
  v_sub_f32 v64, v64, v16
  v_sub_f32 v65, v65, v16
  v_sub_f32 v66, v66, v16
  v_sub_f32 v67, v67, v16
  v_sub_f32 v68, v68, v16
  v_sub_f32 v69, v69, v16
  v_sub_f32 v70, v70, v16
  v_sub_f32 v71, v71, v16
  v_exp_f32 v64, v64
  v_exp_f32 v65, v65
  v_exp_f32 v66, v66
  v_exp_f32 v67, v67
  v_exp_f32 v68, v68
  v_exp_f32 v69, v69
  v_exp_f32 v70, v70
  v_exp_f32 v71, v71
  v_mov_b32 v27, 0
  v_cvt_pk_bf16_f32 v56, v64, v27
  v_cvt_pk_bf16_f32 v57, v65, v27
  v_cvt_pk_bf16_f32 v58, v66, v27
  v_cvt_pk_bf16_f32 v59, v67, v27
  v_cvt_pk_bf16_f32 v60, v68, v27
  v_cvt_pk_bf16_f32 v61, v69, v27
  v_cvt_pk_bf16_f32 v62, v70, v27
  v_cvt_pk_bf16_f32 v63, v71, v27
  ds_write_b128 v3, v[56:59]
  ds_write_b128 v3, v[60:63] offset:16
  v_add_f32 v17, v64, v65
  v_add_f32 v17, v17, v66
  v_add_f32 v17, v17, v67
  v_add_f32 v17, v17, v68
  v_add_f32 v17, v17, v69
  v_add_f32 v17, v17, v70
  v_add_f32 v17, v17, v71
  s_waitcnt lgkmcnt(0)
  s_barrier
  v_add_f32_dpp v17, v17, v17 quad_perm:[1,0,3,2] row_mask:0xf bank_mask:0xf
  s_nop 1
  v_add_f32_dpp v17, v17, v17 quad_perm:[2,3,0,1] row_mask:0xf bank_mask:0xf
  s_nop 1
  v_add_f32_dpp v17, v17, v17 row_ror:4 row_mask:0xf bank_mask:0xf
  s_nop 1
  v_add_f32_dpp v17, v17, v17 row_ror:8 row_mask:0xf bank_mask:0xf
  v_mov_b32 v27, v17
  s_nop 1
  v_permlane32_swap_b32 v17, v27
  v_add_f32 v17, v17, v27
  v_mov_b32 v27, v17
  s_nop 1
  v_permlane16_swap_b32 v17, v27
  v_add_f32 v17, v17, v27
  s_lshl_b32 s51, s47, 2
  s_add_u32 s51, s51, 155712
  v_mov_b32 v2, s51
  s_mov_b64 exec, 1
  ds_write_b32 v2, v17
  s_mov_b64 exec, -1
  s_cmp_lt_u32 s47, 5
  s_cbranch_scc1 attn_main_kernel_vfirst
  v_lshrrev_b32 v28, 2, v33
  v_lshl_add_u32 v28, v32, 3, v28
  v_mul_u32_u24 v28, 1056, v28
  v_and_b32 v29, 3, v33
  v_lshl_add_u32 v28, v29, 3, v28
  s_lshl_b32 s51, s47, 7
  v_add_u32 v28, s51, v28
  v_add_u32 v29, 67584, v28
  ds_read_b64_tr_b16 v[72:73], v28 offset:0
  ds_read_b64_tr_b16 v[74:75], v28 offset:4224
  ds_read_b64_tr_b16 v[76:77], v28 offset:32
  ds_read_b64_tr_b16 v[78:79], v28 offset:4256
  ds_read_b64_tr_b16 v[80:81], v28 offset:64
  ds_read_b64_tr_b16 v[82:83], v28 offset:4288
  ds_read_b64_tr_b16 v[84:85], v28 offset:96
  ds_read_b64_tr_b16 v[86:87], v28 offset:4320
  ds_read_b64_tr_b16 v[88:89], v28 offset:33792
  ds_read_b64_tr_b16 v[90:91], v28 offset:38016
  ds_read_b64_tr_b16 v[92:93], v28 offset:33824
  ds_read_b64_tr_b16 v[94:95], v28 offset:38048
  ds_read_b64_tr_b16 v[96:97], v28 offset:33856
  ds_read_b64_tr_b16 v[98:99], v28 offset:38080
  ds_read_b64_tr_b16 v[100:101], v28 offset:33888
  ds_read_b64_tr_b16 v[102:103], v28 offset:38112
  ds_read_b64_tr_b16 v[104:105], v29 offset:0
  ds_read_b64_tr_b16 v[106:107], v29 offset:4224
  ds_read_b64_tr_b16 v[108:109], v29 offset:32
  ds_read_b64_tr_b16 v[110:111], v29 offset:4256
  ds_read_b64_tr_b16 v[112:113], v29 offset:64
  ds_read_b64_tr_b16 v[114:115], v29 offset:4288
  ds_read_b64_tr_b16 v[116:117], v29 offset:96
  ds_read_b64_tr_b16 v[118:119], v29 offset:4320
  ds_read_b64_tr_b16 v[120:121], v29 offset:33792
  ds_read_b64_tr_b16 v[122:123], v29 offset:38016
  ds_read_b64_tr_b16 v[124:125], v29 offset:33824
  ds_read_b64_tr_b16 v[126:127], v29 offset:38048
  ds_read_b64_tr_b16 v[128:129], v29 offset:33856
  ds_read_b64_tr_b16 v[130:131], v29 offset:38080
  ds_read_b64_tr_b16 v[132:133], v29 offset:33888
  ds_read_b64_tr_b16 v[134:135], v29 offset:38112
attn_main_kernel_bw:
  ds_read_b32 v2, v34
  s_waitcnt lgkmcnt(0)
  v_readfirstlane_b32 s3, v2
  s_nop 3
  s_cmp_ge_u32 s3, 480
  s_cbranch_scc1 attn_main_kernel_bj
  s_sleep 8
  s_branch attn_main_kernel_bw
attn_main_kernel_bj:
  s_mov_b64 exec, 1
  ds_add_rtn_u32 v2, v34, v35
  s_mov_b64 exec, -1
  s_waitcnt lgkmcnt(0)
  v_readfirstlane_b32 s48, v2
  s_nop 3
  s_and_b32 s46, s48, 255
  s_lshl_b32 s56, s46, 12
  s_add_u32 s56, s56, s53
  s_cmp_lt_u32 s48, 256
  s_cselect_b32 s80, s20, s24
  s_cselect_b32 s81, s21, s25
  s_cmp_lt_u32 s48, 512
  s_cselect_b32 s82, s22, 0
  s_cmp_ge_u32 s48, 512
  s_cbranch_scc1 attn_main_kernel_vdone
  s_waitcnt vmcnt(0)
  buffer_load_dwordx4 v[40:43], v1, s[80:83], s56 offen offset:0 nt
  buffer_load_dwordx4 v[44:47], v1, s[80:83], s56 offen offset:1024 nt
  buffer_load_dwordx4 v[48:51], v1, s[80:83], s56 offen offset:2048 nt
  buffer_load_dwordx4 v[52:55], v1, s[80:83], s56 offen offset:3072 nt
  s_branch attn_main_kernel_vloop
attn_main_kernel_vfirst:
  s_and_b32 s46, s57, 255
  s_lshl_b32 s46, s46, 6
  v_add_u32 v3, s46, v37
  ds_read_b32 v24, v3
  s_and_b32 s46, s48, 255
  s_lshl_b32 s46, s46, 6
  v_add_u32 v3, s46, v37
  ds_read_b32 v20, v3
  s_mov_b64 exec, 1
  ds_add_rtn_u32 v2, v34, v35
  s_mov_b64 exec, -1
  s_waitcnt lgkmcnt(0)
  v_readfirstlane_b32 s48, v2
  s_nop 3
  s_and_b32 s46, s48, 255
  s_lshl_b32 s56, s46, 12
  s_add_u32 s56, s56, s53
  s_cmp_lt_u32 s48, 256
  s_cselect_b32 s80, s20, s24
  s_cselect_b32 s81, s21, s25
  s_cmp_lt_u32 s48, 512
  s_cselect_b32 s82, s22, 0
  v_lshlrev_b32 v25, 16, v24
  s_waitcnt vmcnt(7)
  v_dot2c_f32_bf16_dpp v8, v24, v40 row_newbcast:0 row_mask:0xf bank_mask:0xf
  v_dot2c_f32_bf16_dpp v9, v25, v40 row_newbcast:0 row_mask:0xf bank_mask:0xf
  v_dot2c_f32_bf16_dpp v10, v24, v41 row_newbcast:0 row_mask:0xf bank_mask:0xf
  v_dot2c_f32_bf16_dpp v11, v25, v41 row_newbcast:0 row_mask:0xf bank_mask:0xf
  v_dot2c_f32_bf16_dpp v12, v24, v42 row_newbcast:0 row_mask:0xf bank_mask:0xf
  v_dot2c_f32_bf16_dpp v13, v25, v42 row_newbcast:0 row_mask:0xf bank_mask:0xf
  v_dot2c_f32_bf16_dpp v14, v24, v43 row_newbcast:0 row_mask:0xf bank_mask:0xf
  v_dot2c_f32_bf16_dpp v15, v25, v43 row_newbcast:0 row_mask:0xf bank_mask:0xf
  buffer_load_dwordx4 v[40:43], v1, s[80:83], s56 offen offset:0 nt
  s_waitcnt vmcnt(7)
  v_dot2c_f32_bf16_dpp v8, v24, v44 row_newbcast:4 row_mask:0xf bank_mask:0xf
  v_dot2c_f32_bf16_dpp v9, v25, v44 row_newbcast:4 row_mask:0xf bank_mask:0xf
  v_dot2c_f32_bf16_dpp v10, v24, v45 row_newbcast:4 row_mask:0xf bank_mask:0xf
  v_dot2c_f32_bf16_dpp v11, v25, v45 row_newbcast:4 row_mask:0xf bank_mask:0xf
  v_dot2c_f32_bf16_dpp v12, v24, v46 row_newbcast:4 row_mask:0xf bank_mask:0xf
  v_dot2c_f32_bf16_dpp v13, v25, v46 row_newbcast:4 row_mask:0xf bank_mask:0xf
  v_dot2c_f32_bf16_dpp v14, v24, v47 row_newbcast:4 row_mask:0xf bank_mask:0xf
  v_dot2c_f32_bf16_dpp v15, v25, v47 row_newbcast:4 row_mask:0xf bank_mask:0xf
  buffer_load_dwordx4 v[44:47], v1, s[80:83], s56 offen offset:1024 nt
  s_waitcnt vmcnt(7)
  v_dot2c_f32_bf16_dpp v8, v24, v48 row_newbcast:8 row_mask:0xf bank_mask:0xf
  v_dot2c_f32_bf16_dpp v9, v25, v48 row_newbcast:8 row_mask:0xf bank_mask:0xf
  v_dot2c_f32_bf16_dpp v10, v24, v49 row_newbcast:8 row_mask:0xf bank_mask:0xf
  v_dot2c_f32_bf16_dpp v11, v25, v49 row_newbcast:8 row_mask:0xf bank_mask:0xf
  v_dot2c_f32_bf16_dpp v12, v24, v50 row_newbcast:8 row_mask:0xf bank_mask:0xf
  v_dot2c_f32_bf16_dpp v13, v25, v50 row_newbcast:8 row_mask:0xf bank_mask:0xf
  v_dot2c_f32_bf16_dpp v14, v24, v51 row_newbcast:8 row_mask:0xf bank_mask:0xf
  v_dot2c_f32_bf16_dpp v15, v25, v51 row_newbcast:8 row_mask:0xf bank_mask:0xf
  buffer_load_dwordx4 v[48:51], v1, s[80:83], s56 offen offset:2048 nt
  s_waitcnt vmcnt(7)
  v_dot2c_f32_bf16_dpp v8, v24, v52 row_newbcast:12 row_mask:0xf bank_mask:0xf
  v_dot2c_f32_bf16_dpp v9, v25, v52 row_newbcast:12 row_mask:0xf bank_mask:0xf
  v_dot2c_f32_bf16_dpp v10, v24, v53 row_newbcast:12 row_mask:0xf bank_mask:0xf
  v_dot2c_f32_bf16_dpp v11, v25, v53 row_newbcast:12 row_mask:0xf bank_mask:0xf
  v_dot2c_f32_bf16_dpp v12, v24, v54 row_newbcast:12 row_mask:0xf bank_mask:0xf
  v_dot2c_f32_bf16_dpp v13, v25, v54 row_newbcast:12 row_mask:0xf bank_mask:0xf
  v_dot2c_f32_bf16_dpp v14, v24, v55 row_newbcast:12 row_mask:0xf bank_mask:0xf
  v_dot2c_f32_bf16_dpp v15, v25, v55 row_newbcast:12 row_mask:0xf bank_mask:0xf
  buffer_load_dwordx4 v[52:55], v1, s[80:83], s56 offen offset:3072 nt
  v_lshlrev_b32 v21, 16, v20
  s_waitcnt vmcnt(7)
  v_dot2c_f32_bf16_dpp v8, v20, v72 row_newbcast:0 row_mask:0xf bank_mask:0xf
  v_dot2c_f32_bf16_dpp v9, v21, v72 row_newbcast:0 row_mask:0xf bank_mask:0xf
  v_dot2c_f32_bf16_dpp v10, v20, v73 row_newbcast:0 row_mask:0xf bank_mask:0xf
  v_dot2c_f32_bf16_dpp v11, v21, v73 row_newbcast:0 row_mask:0xf bank_mask:0xf
  v_dot2c_f32_bf16_dpp v12, v20, v74 row_newbcast:0 row_mask:0xf bank_mask:0xf
  v_dot2c_f32_bf16_dpp v13, v21, v74 row_newbcast:0 row_mask:0xf bank_mask:0xf
  v_dot2c_f32_bf16_dpp v14, v20, v75 row_newbcast:0 row_mask:0xf bank_mask:0xf
  v_dot2c_f32_bf16_dpp v15, v21, v75 row_newbcast:0 row_mask:0xf bank_mask:0xf
  s_waitcnt vmcnt(6)
  v_dot2c_f32_bf16_dpp v8, v20, v76 row_newbcast:4 row_mask:0xf bank_mask:0xf
  v_dot2c_f32_bf16_dpp v9, v21, v76 row_newbcast:4 row_mask:0xf bank_mask:0xf
  v_dot2c_f32_bf16_dpp v10, v20, v77 row_newbcast:4 row_mask:0xf bank_mask:0xf
  v_dot2c_f32_bf16_dpp v11, v21, v77 row_newbcast:4 row_mask:0xf bank_mask:0xf
  v_dot2c_f32_bf16_dpp v12, v20, v78 row_newbcast:4 row_mask:0xf bank_mask:0xf
  v_dot2c_f32_bf16_dpp v13, v21, v78 row_newbcast:4 row_mask:0xf bank_mask:0xf
  v_dot2c_f32_bf16_dpp v14, v20, v79 row_newbcast:4 row_mask:0xf bank_mask:0xf
  v_dot2c_f32_bf16_dpp v15, v21, v79 row_newbcast:4 row_mask:0xf bank_mask:0xf
  s_waitcnt vmcnt(5)
  v_dot2c_f32_bf16_dpp v8, v20, v80 row_newbcast:8 row_mask:0xf bank_mask:0xf
  v_dot2c_f32_bf16_dpp v9, v21, v80 row_newbcast:8 row_mask:0xf bank_mask:0xf
  v_dot2c_f32_bf16_dpp v10, v20, v81 row_newbcast:8 row_mask:0xf bank_mask:0xf
  v_dot2c_f32_bf16_dpp v11, v21, v81 row_newbcast:8 row_mask:0xf bank_mask:0xf
  v_dot2c_f32_bf16_dpp v12, v20, v82 row_newbcast:8 row_mask:0xf bank_mask:0xf
  v_dot2c_f32_bf16_dpp v13, v21, v82 row_newbcast:8 row_mask:0xf bank_mask:0xf
  v_dot2c_f32_bf16_dpp v14, v20, v83 row_newbcast:8 row_mask:0xf bank_mask:0xf
  v_dot2c_f32_bf16_dpp v15, v21, v83 row_newbcast:8 row_mask:0xf bank_mask:0xf
  s_waitcnt vmcnt(4)
  v_dot2c_f32_bf16_dpp v8, v20, v84 row_newbcast:12 row_mask:0xf bank_mask:0xf
  v_dot2c_f32_bf16_dpp v9, v21, v84 row_newbcast:12 row_mask:0xf bank_mask:0xf
  v_dot2c_f32_bf16_dpp v10, v20, v85 row_newbcast:12 row_mask:0xf bank_mask:0xf
  v_dot2c_f32_bf16_dpp v11, v21, v85 row_newbcast:12 row_mask:0xf bank_mask:0xf
  v_dot2c_f32_bf16_dpp v12, v20, v86 row_newbcast:12 row_mask:0xf bank_mask:0xf
  v_dot2c_f32_bf16_dpp v13, v21, v86 row_newbcast:12 row_mask:0xf bank_mask:0xf
  v_dot2c_f32_bf16_dpp v14, v20, v87 row_newbcast:12 row_mask:0xf bank_mask:0xf
  v_dot2c_f32_bf16_dpp v15, v21, v87 row_newbcast:12 row_mask:0xf bank_mask:0xf
  v_lshrrev_b32 v28, 2, v33
  v_lshl_add_u32 v28, v32, 3, v28
  v_mul_u32_u24 v28, 1056, v28
  v_and_b32 v29, 3, v33
  v_lshl_add_u32 v28, v29, 3, v28
  s_lshl_b32 s51, s47, 7
  v_add_u32 v28, s51, v28
  v_add_u32 v29, 67584, v28
  ds_read_b64_tr_b16 v[72:73], v28 offset:0
  ds_read_b64_tr_b16 v[74:75], v28 offset:4224
  ds_read_b64_tr_b16 v[76:77], v28 offset:32
  ds_read_b64_tr_b16 v[78:79], v28 offset:4256
  ds_read_b64_tr_b16 v[80:81], v28 offset:64
  ds_read_b64_tr_b16 v[82:83], v28 offset:4288
  ds_read_b64_tr_b16 v[84:85], v28 offset:96
  ds_read_b64_tr_b16 v[86:87], v28 offset:4320
  ds_read_b64_tr_b16 v[88:89], v28 offset:33792
  ds_read_b64_tr_b16 v[90:91], v28 offset:38016
  ds_read_b64_tr_b16 v[92:93], v28 offset:33824
  ds_read_b64_tr_b16 v[94:95], v28 offset:38048
  ds_read_b64_tr_b16 v[96:97], v28 offset:33856
  ds_read_b64_tr_b16 v[98:99], v28 offset:38080
  ds_read_b64_tr_b16 v[100:101], v28 offset:33888
  ds_read_b64_tr_b16 v[102:103], v28 offset:38112
  ds_read_b64_tr_b16 v[104:105], v29 offset:0
  ds_read_b64_tr_b16 v[106:107], v29 offset:4224
  ds_read_b64_tr_b16 v[108:109], v29 offset:32
  ds_read_b64_tr_b16 v[110:111], v29 offset:4256
  ds_read_b64_tr_b16 v[112:113], v29 offset:64
  ds_read_b64_tr_b16 v[114:115], v29 offset:4288
  ds_read_b64_tr_b16 v[116:117], v29 offset:96
  ds_read_b64_tr_b16 v[118:119], v29 offset:4320
  ds_read_b64_tr_b16 v[120:121], v29 offset:33792
  ds_read_b64_tr_b16 v[122:123], v29 offset:38016
  ds_read_b64_tr_b16 v[124:125], v29 offset:33824
  ds_read_b64_tr_b16 v[126:127], v29 offset:38048
  ds_read_b64_tr_b16 v[128:129], v29 offset:33856
  ds_read_b64_tr_b16 v[130:131], v29 offset:38080
  ds_read_b64_tr_b16 v[132:133], v29 offset:33888
  ds_read_b64_tr_b16 v[134:135], v29 offset:38112
attn_main_kernel_vloop:
  s_and_b32 s46, s48, 255
  s_lshl_b32 s46, s46, 6
  v_add_u32 v3, s46, v37
  ds_read_b32 v24, v3
  s_mov_b64 exec, 1
  ds_add_rtn_u32 v2, v34, v35
  s_mov_b64 exec, -1
  s_waitcnt lgkmcnt(0)
  v_readfirstlane_b32 s48, v2
  s_nop 3
  s_and_b32 s46, s48, 255
  s_lshl_b32 s56, s46, 12
  s_add_u32 s56, s56, s53
  s_cmp_lt_u32 s48, 256
  s_cselect_b32 s80, s20, s24
  s_cselect_b32 s81, s21, s25
  s_cmp_lt_u32 s48, 512
  s_cselect_b32 s82, s22, 0
  v_lshlrev_b32 v25, 16, v24
  s_waitcnt vmcnt(3)
  v_dot2c_f32_bf16_dpp v8, v24, v40 row_newbcast:0 row_mask:0xf bank_mask:0xf
  v_dot2c_f32_bf16_dpp v9, v25, v40 row_newbcast:0 row_mask:0xf bank_mask:0xf
  v_dot2c_f32_bf16_dpp v10, v24, v41 row_newbcast:0 row_mask:0xf bank_mask:0xf
  v_dot2c_f32_bf16_dpp v11, v25, v41 row_newbcast:0 row_mask:0xf bank_mask:0xf
  v_dot2c_f32_bf16_dpp v12, v24, v42 row_newbcast:0 row_mask:0xf bank_mask:0xf
  v_dot2c_f32_bf16_dpp v13, v25, v42 row_newbcast:0 row_mask:0xf bank_mask:0xf
  v_dot2c_f32_bf16_dpp v14, v24, v43 row_newbcast:0 row_mask:0xf bank_mask:0xf
  v_dot2c_f32_bf16_dpp v15, v25, v43 row_newbcast:0 row_mask:0xf bank_mask:0xf
  buffer_load_dwordx4 v[40:43], v1, s[80:83], s56 offen offset:0 nt
  s_waitcnt vmcnt(3)
  v_dot2c_f32_bf16_dpp v8, v24, v44 row_newbcast:4 row_mask:0xf bank_mask:0xf
  v_dot2c_f32_bf16_dpp v9, v25, v44 row_newbcast:4 row_mask:0xf bank_mask:0xf
  v_dot2c_f32_bf16_dpp v10, v24, v45 row_newbcast:4 row_mask:0xf bank_mask:0xf
  v_dot2c_f32_bf16_dpp v11, v25, v45 row_newbcast:4 row_mask:0xf bank_mask:0xf
  v_dot2c_f32_bf16_dpp v12, v24, v46 row_newbcast:4 row_mask:0xf bank_mask:0xf
  v_dot2c_f32_bf16_dpp v13, v25, v46 row_newbcast:4 row_mask:0xf bank_mask:0xf
  v_dot2c_f32_bf16_dpp v14, v24, v47 row_newbcast:4 row_mask:0xf bank_mask:0xf
  v_dot2c_f32_bf16_dpp v15, v25, v47 row_newbcast:4 row_mask:0xf bank_mask:0xf
  buffer_load_dwordx4 v[44:47], v1, s[80:83], s56 offen offset:1024 nt
  s_waitcnt vmcnt(3)
  v_dot2c_f32_bf16_dpp v8, v24, v48 row_newbcast:8 row_mask:0xf bank_mask:0xf
  v_dot2c_f32_bf16_dpp v9, v25, v48 row_newbcast:8 row_mask:0xf bank_mask:0xf
  v_dot2c_f32_bf16_dpp v10, v24, v49 row_newbcast:8 row_mask:0xf bank_mask:0xf
  v_dot2c_f32_bf16_dpp v11, v25, v49 row_newbcast:8 row_mask:0xf bank_mask:0xf
  v_dot2c_f32_bf16_dpp v12, v24, v50 row_newbcast:8 row_mask:0xf bank_mask:0xf
  v_dot2c_f32_bf16_dpp v13, v25, v50 row_newbcast:8 row_mask:0xf bank_mask:0xf
  v_dot2c_f32_bf16_dpp v14, v24, v51 row_newbcast:8 row_mask:0xf bank_mask:0xf
  v_dot2c_f32_bf16_dpp v15, v25, v51 row_newbcast:8 row_mask:0xf bank_mask:0xf
  buffer_load_dwordx4 v[48:51], v1, s[80:83], s56 offen offset:2048 nt
  s_waitcnt vmcnt(3)
  v_dot2c_f32_bf16_dpp v8, v24, v52 row_newbcast:12 row_mask:0xf bank_mask:0xf
  v_dot2c_f32_bf16_dpp v9, v25, v52 row_newbcast:12 row_mask:0xf bank_mask:0xf
  v_dot2c_f32_bf16_dpp v10, v24, v53 row_newbcast:12 row_mask:0xf bank_mask:0xf
  v_dot2c_f32_bf16_dpp v11, v25, v53 row_newbcast:12 row_mask:0xf bank_mask:0xf
  v_dot2c_f32_bf16_dpp v12, v24, v54 row_newbcast:12 row_mask:0xf bank_mask:0xf
  v_dot2c_f32_bf16_dpp v13, v25, v54 row_newbcast:12 row_mask:0xf bank_mask:0xf
  v_dot2c_f32_bf16_dpp v14, v24, v55 row_newbcast:12 row_mask:0xf bank_mask:0xf
  v_dot2c_f32_bf16_dpp v15, v25, v55 row_newbcast:12 row_mask:0xf bank_mask:0xf
  buffer_load_dwordx4 v[52:55], v1, s[80:83], s56 offen offset:3072 nt
  s_cmp_lt_u32 s48, 512
  s_cbranch_scc1 attn_main_kernel_vloop
attn_main_kernel_vdone:
  v_lshlrev_b32 v2, 4, v33
  v_lshl_add_u32 v2, v32, 2, v2
  v_permlane32_swap_b32 v8, v12
  v_permlane32_swap_b32 v9, v13
  v_permlane32_swap_b32 v10, v14
  v_permlane32_swap_b32 v11, v15
  v_add_f32 v8, v8, v12
  v_add_f32 v9, v9, v13
  v_add_f32 v10, v10, v14
  v_add_f32 v11, v11, v15
  s_nop 0
  v_permlane16_swap_b32 v8, v10
  v_permlane16_swap_b32 v9, v11
  v_add_f32 v8, v8, v10
  v_add_f32 v9, v9, v11
  s_lshl_b32 s51, s47, 8
  s_add_u32 s51, s51, 151552
  v_add_u32 v27, s51, v2
  v_cvt_pk_bf16_f32 v10, v8, v9
  ds_write_b32 v27, v10
  v_and_b32 v3, 7, v33
  v_lshlrev_b32 v3, 8, v3
  v_lshl_add_u32 v3, v32, 4, v3
  v_add_u32 v3, 151552, v3
  v_mov_b32 v2, 155712
  s_lshl_b32 s46, s58, 11
  s_lshl_b32 s3, s58, 3
  s_add_u32 s3, s3, 524288
  s_waitcnt vmcnt(0) lgkmcnt(0)
  s_barrier
  ds_read_b128 v[40:43], v3 offset:0
  ds_read_b128 v[44:47], v3 offset:64
  ds_read_b128 v[48:51], v3 offset:128
  ds_read_b128 v[52:55], v3 offset:192
  ds_read_b128 v[8:11], v2 offset:0
  ds_read_b128 v[12:15], v2 offset:16
  s_waitcnt lgkmcnt(5)
  v_mfma_f32_16x16x32_bf16 v[56:59], v[40:43], v[72:75], 0
  v_mfma_f32_16x16x32_bf16 v[60:63], v[40:43], v[76:79], 0
  v_mfma_f32_16x16x32_bf16 v[64:67], v[40:43], v[80:83], 0
  v_mfma_f32_16x16x32_bf16 v[68:71], v[40:43], v[84:87], 0
  s_waitcnt lgkmcnt(4)
  v_mfma_f32_16x16x32_bf16 v[56:59], v[44:47], v[88:91], v[56:59]
  v_mfma_f32_16x16x32_bf16 v[60:63], v[44:47], v[92:95], v[60:63]
  v_mfma_f32_16x16x32_bf16 v[64:67], v[44:47], v[96:99], v[64:67]
  v_mfma_f32_16x16x32_bf16 v[68:71], v[44:47], v[100:103], v[68:71]
  s_waitcnt lgkmcnt(3)
  v_mfma_f32_16x16x32_bf16 v[56:59], v[48:51], v[104:107], v[56:59]
  v_mfma_f32_16x16x32_bf16 v[60:63], v[48:51], v[108:111], v[60:63]
  v_mfma_f32_16x16x32_bf16 v[64:67], v[48:51], v[112:115], v[64:67]
  v_mfma_f32_16x16x32_bf16 v[68:71], v[48:51], v[116:119], v[68:71]
  s_waitcnt lgkmcnt(2)
  v_mfma_f32_16x16x32_bf16 v[56:59], v[52:55], v[120:123], v[56:59]
  v_mfma_f32_16x16x32_bf16 v[60:63], v[52:55], v[124:127], v[60:63]
  v_mfma_f32_16x16x32_bf16 v[64:67], v[52:55], v[128:131], v[64:67]
  v_mfma_f32_16x16x32_bf16 v[68:71], v[52:55], v[132:135], v[68:71]
  s_waitcnt lgkmcnt(0)
  v_add_f32 v17, v8, v9
  v_add_f32 v17, v17, v10
  v_add_f32 v17, v17, v11
  v_add_f32 v17, v17, v12
  v_add_f32 v17, v17, v13
  v_add_f32 v17, v17, v14
  v_add_f32 v17, v17, v15
  v_mov_b32 v26, v16
  v_mov_b32 v27, v17
  v_add_f32 v56, v56, v57
  v_add_f32 v58, v58, v59
  v_add_f32 v60, v60, v61
  v_add_f32 v62, v62, v63
  v_add_f32 v64, v64, v65
  v_add_f32 v66, v66, v67
  v_add_f32 v68, v68, v69
  v_add_f32 v70, v70, v71
  v_add_f32 v56, v56, v58
  v_add_f32 v60, v60, v62
  v_add_f32 v64, v64, v66
  v_add_f32 v68, v68, v70
  v_permlane16_swap_b32 v56, v60
  s_nop 0
  v_permlane16_swap_b32 v64, v68
  v_add_f32 v72, v56, v60
  v_add_f32 v64, v64, v68
  s_mov_b32 exec_lo, 0
  v_mov_b32 v72, v64
  s_mov_b64 exec, -1
  buffer_store_dword v72, v36, s[36:39], s46 offen
  s_cmp_lg_u32 s47, 0
  s_cbranch_scc1 attn_main_kernel_end
  v_mov_b32 v2, 0
  s_mov_b64 exec, 1
  buffer_store_dwordx2 v[26:27], v2, s[36:39], s3 offen
attn_main_kernel_end:
  s_endpgm
.section .rodata,"a"
.p2align 6
.amdhsa_kernel attn_main_kernel
  .amdhsa_next_free_vgpr 136
  .amdhsa_next_free_sgpr 96
  .amdhsa_accum_offset 136
  .amdhsa_group_segment_fixed_size 0
  .amdhsa_kernarg_size 104
  .amdhsa_user_sgpr_count 2
  .amdhsa_user_sgpr_kernarg_segment_ptr 1
  .amdhsa_system_sgpr_workgroup_id_x 1
  .amdhsa_float_denorm_mode_32 3
  .amdhsa_float_denorm_mode_16_64 3
.end_amdhsa_kernel
.text
.globl fin2_kernel
.p2align 8
.type fin2_kernel,@function
fin2_kernel:

  s_load_dwordx2 s[4:5], s[0:1], 96
  s_load_dwordx2 s[6:7], s[0:1], 80
  s_cmp_ge_u32 s2, 32
  s_cbranch_scc1 fin2_kernel_end
  v_lshrrev_b32 v1, 6, v0
  v_and_b32 v2, 63, v0
  v_readfirstlane_b32 s8, v1
  v_lshrrev_b32 v3, 2, v2
  v_and_b32 v4, 3, v2
  s_lshl_b32 s9, s2, 2
  s_add_u32 s9, s9, s8
  s_lshr_b32 s10, s9, 5
  s_and_b32 s11, s9, 31
  v_lshlrev_b32 v5, 13, v3
  v_lshl_add_u32 v5, v4, 4, v5
  v_add_u32 v6, 4096, v5
  v_lshlrev_b32 v7, 5, v3
  s_lshl_b32 s12, s10, 17
  s_lshl_b32 s13, s11, 6
  s_add_u32 s12, s12, s13
  s_lshl_b32 s14, s10, 9
  s_add_u32 s14, s14, 524288
  s_waitcnt lgkmcnt(0)
  s_mov_b32 s20, s4
  s_and_b32 s21, s5, 0xffff
  s_mov_b32 s22, 526336
  s_mov_b32 s23, 0x20000
  buffer_load_dwordx4 v[8:11], v7, s[20:23], s14 offen
  buffer_load_dwordx4 v[12:15], v7, s[20:23], s14 offen offset:16
  buffer_load_dwordx4 v[16:19], v5, s[20:23], s12 offen
  buffer_load_dwordx4 v[20:23], v5, s[20:23], s12 offen offset:2048
  buffer_load_dwordx4 v[24:27], v6, s[20:23], s12 offen
  buffer_load_dwordx4 v[28:31], v6, s[20:23], s12 offen offset:2048
  s_mov_b32 s24, s6
  s_and_b32 s25, s7, 0xffff
  s_mov_b32 s26, 4096
  s_mov_b32 s27, 0x20000
  s_and_b32 s15, s10, 1
  s_lshr_b32 s18, s10, 1
  s_lshl_b32 s15, s15, 11
  s_lshl_b32 s18, s18, 10
  s_add_u32 s15, s15, s18
  s_lshl_b32 s18, s11, 5
  s_add_u32 s15, s15, s18
  v_lshrrev_b32 v34, 4, v2
  v_lshl_add_u32 v34, v4, 2, v34
  v_lshlrev_b32 v34, 1, v34
  s_waitcnt vmcnt(4)
  v_max_f32 v32, v8, v10
  v_max_f32 v33, v12, v14
  v_sub_f32 v8, v8, v32
  v_sub_f32 v10, v10, v32
  v_sub_f32 v12, v12, v33
  v_sub_f32 v14, v14, v33
  v_exp_f32 v8, v8
  v_exp_f32 v10, v10
  v_exp_f32 v12, v12
  v_exp_f32 v14, v14
  v_mul_f32 v32, v8, v9
  v_mul_f32 v33, v12, v13
  v_fma_f32 v32, v10, v11, v32
  v_fma_f32 v33, v14, v15, v33
  v_rcp_f32 v32, v32
  v_rcp_f32 v33, v33
  v_mul_f32 v8, v8, v32
  v_mul_f32 v10, v10, v32
  v_mul_f32 v12, v12, v33
  v_mul_f32 v14, v14, v33
  s_waitcnt vmcnt(0)
  v_mul_f32 v36, v8, v16
  v_mul_f32 v37, v8, v17
  v_mul_f32 v38, v8, v18
  v_mul_f32 v39, v8, v19
  v_fma_f32 v36, v10, v20, v36
  v_fma_f32 v37, v10, v21, v37
  v_fma_f32 v38, v10, v22, v38
  v_fma_f32 v39, v10, v23, v39
  v_fma_f32 v36, v12, v24, v36
  v_fma_f32 v37, v12, v25, v37
  v_fma_f32 v38, v12, v26, v38
  v_fma_f32 v39, v12, v27, v39
  v_fma_f32 v36, v14, v28, v36
  v_fma_f32 v37, v14, v29, v37
  v_fma_f32 v38, v14, v30, v38
  v_fma_f32 v39, v14, v31, v39
  v_add_f32_dpp v36, v36, v36 row_ror:4 row_mask:0xf bank_mask:0xf
  v_add_f32_dpp v37, v37, v37 row_ror:4 row_mask:0xf bank_mask:0xf
  v_add_f32_dpp v38, v38, v38 row_ror:4 row_mask:0xf bank_mask:0xf
  v_add_f32_dpp v39, v39, v39 row_ror:4 row_mask:0xf bank_mask:0xf
  v_add_f32_dpp v36, v36, v36 row_ror:8 row_mask:0xf bank_mask:0xf
  v_add_f32_dpp v37, v37, v37 row_ror:8 row_mask:0xf bank_mask:0xf
  v_add_f32_dpp v38, v38, v38 row_ror:8 row_mask:0xf bank_mask:0xf
  v_add_f32_dpp v39, v39, v39 row_ror:8 row_mask:0xf bank_mask:0xf
  s_nop 0
  v_permlane32_swap_b32 v36, v38
  v_permlane32_swap_b32 v37, v39
  v_add_f32 v36, v36, v38
  v_add_f32 v37, v37, v39
  s_nop 1
  v_permlane16_swap_b32 v36, v37
  v_add_f32 v36, v36, v37
  v_cvt_pk_bf16_f32 v36, v36, v36
  s_mov_b32 exec_lo, 0x000f000f
  s_mov_b32 exec_hi, 0x000f000f
  buffer_store_short v36, v34, s[24:27], s15 offen
fin2_kernel_end:
  s_endpgm
.section .rodata,"a"
.p2align 6
.amdhsa_kernel fin2_kernel
  .amdhsa_next_free_vgpr 48
  .amdhsa_next_free_sgpr 40
  .amdhsa_accum_offset 48
  .amdhsa_group_segment_fixed_size 0
  .amdhsa_kernarg_size 104
  .amdhsa_user_sgpr_count 2
  .amdhsa_user_sgpr_kernarg_segment_ptr 1
  .amdhsa_system_sgpr_workgroup_id_x 1
  .amdhsa_float_denorm_mode_32 3
  .amdhsa_float_denorm_mode_16_64 3
.end_amdhsa_kernel
```
